```python
import torch

def _softmax(x, axis=-1):
    return torch.softmax(x, dim=axis)
def _gelu(x):
    return torch.nn.functional.gelu(x, approximate="tanh")
def _silu(x):
    return torch.nn.functional.silu(x)
def _sigmoid(x):
    return torch.sigmoid(x)
def _layernorm(x, axis=-1, eps=1e-5):
    m = x.mean(dim=axis, keepdim=True)
    v = x.var(dim=axis, keepdim=True, unbiased=False)
    return (x - m) / torch.sqrt(v + eps)
def _scatter_add(tgt, idx, src, axis=0):
    return tgt.clone().index_add_(axis, idx, src)
def _segment_sum(src, seg, n):
    out = torch.zeros((n,) + src.shape[1:], dtype=src.dtype)
    return out.index_add_(0, seg, src)
def _pad(x, pw):
    flat = tuple(v for pair in reversed(pw) for v in pair)
    return torch.nn.functional.pad(x, flat)

kernel_name = 'recurrent_scan__sliding_block_cached__swiglu_ffn__decode'

def setup_inputs():

    _w = (lambda a: (lambda t: t.to(torch.bfloat16) if t.is_floating_point() else t)(torch.as_tensor(a)))
    def _A_setup():
        B, Sq, D = 1, 1, 576
        Hq, Hkv, Sk, Dh = 32, 16, 65536, 128
        assert Hq % Hkv == 0, (Hq, Hkv)
        return {
            "x": _w((lambda *s: torch.randn(*s, dtype=torch.bfloat16) * 0.05)(B, Sq, D)),
            "k_cache": _w((lambda *s: torch.randn(*s, dtype=torch.bfloat16) * 0.8)(B, Hkv, Sk, Dh)),
            "v_cache": _w((lambda *s: torch.randn(*s, dtype=torch.bfloat16) * 0.2)(B, Hkv, Sk, Dh)),
            "wq": _w((lambda *s: torch.randn(*s, dtype=torch.bfloat16) * 0.8)(D, Hq * Dh) * (D ** -0.5)),
            "wo": _w((lambda *s: torch.randn(*s, dtype=torch.bfloat16) * 0.2)(Hq * Dh, D) * ((Hq * Dh) ** -0.5)),
        }
    _A_in = _A_setup()

    def _B_setup():
        B, S, D, F = 1, 1, 576, 4608
        return {
            "x": _w((lambda *s: torch.randn(*s, dtype=torch.bfloat16) * 0.05)(B, S, D)),
            "w_gate": _w((lambda *s: torch.randn(*s, dtype=torch.bfloat16) * 0.1)(D, F)),
            "w_up": _w((lambda *s: torch.randn(*s, dtype=torch.bfloat16) * 0.1)(D, F)),
            "w_down": _w((lambda *s: torch.randn(*s, dtype=torch.bfloat16) * 0.1)(F, D)),
        }
    _B_in = _B_setup()

    return {
        "A_x": _A_in["x"],
        "A_k_cache": _A_in["k_cache"],
        "A_v_cache": _A_in["v_cache"],
        "A_wq": _A_in["wq"],
        "A_wo": _A_in["wo"],
        "B_x": _B_in["x"],
        "B_w_gate": _B_in["w_gate"],
        "B_w_up": _B_in["w_up"],
        "B_w_down": _B_in["w_down"],
    }

def reference(A_x, A_k_cache, A_v_cache, A_wq, A_wo, B_x, B_w_gate, B_w_up, B_w_down):
    def _A_ref(x, k_cache, v_cache, wq, wo):
        B, Sq, D = x.shape
        Hq, Dh = 32, 128
        Hkv, Sk = k_cache.shape[1], k_cache.shape[2]
        W = min(4096, max(256, Sk // 4))
        rep = Hq // Hkv
        q = (lambda x, *d: x.permute(*d))((x @ wq).reshape(B, Sq, Hq, Dh), 0, 2, 1, 3)
        k = (lambda x, n, axis: torch.repeat_interleave(x, n, dim=axis))(k_cache[:, :, Sk - W:, :], rep, axis=1)
        v = (lambda x, n, axis: torch.repeat_interleave(x, n, dim=axis))(v_cache[:, :, Sk - W:, :], rep, axis=1)
        scores = torch.einsum("bhqd,bhkd->bhqk", q, k) * (Dh ** -0.5)
        p = _softmax(scores, axis=-1)
        o = torch.einsum("bhqk,bhkd->bhqd", p, v)
        return (lambda x, *d: x.permute(*d))(o, 0, 2, 1, 3).reshape(B, Sq, Hq * Dh) @ wo

    def _B_ref(x, w_gate, w_up, w_down):
        g = _silu(x @ w_gate)
        u = x @ w_up
        return (g * u) @ w_down

    x = A_x
    xn = _layernorm(x, axis=-1)
    s = _A_ref(xn, A_k_cache, A_v_cache, A_wq, A_wo)
    g = _silu(_B_ref(xn, B_w_gate, B_w_up, B_w_down))
    return x + s * g
```

```asm
; @launch grid=(256,1,1) block=(1024,1,1) lds=12544
.amdgcn_target "amdgcn-amd-amdhsa--gfx950"
.text
.globl recurrent_scan__sliding_block_cached__swiglu_ffn__decode_kernel
.p2align 8
.type recurrent_scan__sliding_block_cached__swiglu_ffn__decode_kernel,@function
recurrent_scan__sliding_block_cached__swiglu_ffn__decode_kernel:
s_cmp_ge_u32 s2, 256
s_cbranch_scc1 L_END
s_load_dwordx16 s[8:23], s[0:1], 0
s_load_dwordx8 s[24:31], s[0:1], 64
v_lshrrev_b32 v1, 6, v0
v_and_b32 v0, 63, v0
v_readfirstlane_b32 s32, v1
s_and_b32 s35, s2, 7
s_lshr_b32 s36, s2, 3
s_lshr_b32 s33, s2, 7
s_lshl_b32 s33, s33, 3
s_add_u32 s33, s33, s35
s_and_b32 s34, s36, 15
s_mov_b32 s79, 100000
s_mov_b32 s38, 0x05040100
s_mov_b32 s39, 0x07060302
v_mov_b32 v5, 0
v_lshlrev_b32 v6, 2, v0
ds_write_b32 v6, v5
v_lshrrev_b32 v1, 4, v0
v_and_b32 v2, 15, v0
v_bfe_u32 v3, v0, 3, 1
v_and_b32 v4, 7, v0
s_mul_i32 s44, s36, 11
s_lshr_b32 s44, s44, 5
s_mul_i32 s45, s44, 3
s_sub_u32 s41, s36, s45
s_mul_i32 s40, s35, 9
s_add_u32 s40, s40, s44
s_mul_i32 s44, s36, 57
s_lshr_b32 s44, s44, 9
s_mul_i32 s45, s44, 9
s_sub_u32 s43, s36, s45
s_add_u32 s44, s44, 5
s_sub_u32 s45, s36, 27
s_cmp_lt_u32 s36, 27
s_cselect_b32 s44, s44, s45
s_mov_b32 s37, s44
s_lshl_b32 s45, s35, 2
s_add_u32 s45, s45, s44
s_add_u32 s46, s45, 28
s_cmp_lt_u32 s44, 4
s_cselect_b32 s42, s45, s46
s_cmp_lt_u32 s32, 2
s_cbranch_scc1 L_W01
s_cmp_ge_u32 s32, 8
s_cbranch_scc1 L_ATT
s_waitcnt lgkmcnt(0)
s_barrier
s_branch L_GV
L_W01:
s_setprio 3
s_cmp_eq_u32 s32, 1
s_cbranch_scc1 L_W1
s_lshr_b32 s44, s34, 2
s_mul_i32 s48, s44, 144
s_lshl_b32 s45, s48, 13
s_lshl_b32 s46, s33, 9
s_add_u32 s45, s45, s46
s_and_b32 s46, s34, 3
s_lshl_b32 s46, s46, 7
s_add_u32 s45, s45, s46
v_lshlrev_b32 v5, 5, v3
v_lshl_add_u32 v5, v1, 3, v5
v_lshlrev_b32 v6, 13, v5
v_lshl_add_u32 v6, v4, 4, v6
v_add_u32 v6, s45, v6
s_waitcnt lgkmcnt(0)
global_load_dwordx4 v[16:19], v6, s[14:15] nt
v_add_u32 v6, 8192, v6
global_load_dwordx4 v[20:23], v6, s[14:15] nt
v_add_u32 v6, 8192, v6
global_load_dwordx4 v[24:27], v6, s[14:15] nt
v_add_u32 v6, 8192, v6
global_load_dwordx4 v[28:31], v6, s[14:15] nt
v_add_u32 v6, 8192, v6
global_load_dwordx4 v[32:35], v6, s[14:15] nt
v_add_u32 v6, 8192, v6
global_load_dwordx4 v[36:39], v6, s[14:15] nt
v_add_u32 v6, 8192, v6
global_load_dwordx4 v[40:43], v6, s[14:15] nt
v_add_u32 v6, 8192, v6
global_load_dwordx4 v[44:47], v6, s[14:15] nt
v_add_u32 v6, 466944, v6
global_load_dwordx4 v[48:51], v6, s[14:15] nt
v_add_u32 v6, 8192, v6
global_load_dwordx4 v[52:55], v6, s[14:15] nt
v_add_u32 v6, 8192, v6
global_load_dwordx4 v[56:59], v6, s[14:15] nt
v_add_u32 v6, 8192, v6
global_load_dwordx4 v[60:63], v6, s[14:15] nt
v_add_u32 v6, 8192, v6
global_load_dwordx4 v[64:67], v6, s[14:15] nt
v_add_u32 v6, 8192, v6
global_load_dwordx4 v[68:71], v6, s[14:15] nt
v_add_u32 v6, 8192, v6
global_load_dwordx4 v[72:75], v6, s[14:15] nt
v_add_u32 v6, 8192, v6
global_load_dwordx4 v[76:79], v6, s[14:15] nt
v_lshlrev_b32 v7, 3, v3
v_lshl_add_u32 v7, v1, 1, v7
v_add_u32 v8, 128, v7
v_lshlrev_b32 v8, 13, v8
v_lshl_add_u32 v8, v4, 4, v8
v_add_u32 v8, s45, v8
global_load_dwordx4 v[80:83], v8, s[14:15] nt
v_add_u32 v8, 8192, v8
global_load_dwordx4 v[84:87], v8, s[14:15] nt
s_barrier
v_and_b32 v10, 1, v0
v_lshlrev_b32 v10, 5, v10
v_lshl_add_u32 v10, v1, 3, v10
v_add_u32 v10, s48, v10
v_lshlrev_b32 v10, 1, v10
v_and_b32 v11, 1, v0
v_lshlrev_b32 v11, 3, v11
v_lshl_add_u32 v11, v1, 1, v11
v_add_u32 v11, s48, v11
v_lshlrev_b32 v11, 1, v11
s_lshl_b32 s45, s33, 4
s_add_u32 s45, s45, s34
s_lshl_b32 s45, s45, 9
s_add_u32 s45, s45, 65536
v_lshlrev_b32 v9, 7, v1
v_lshl_add_u32 v9, v4, 4, v9
v_add_u32 v9, s45, v9
v_mov_b32 v6, 0
W_1:
ds_read_b32 v5, v6
s_waitcnt lgkmcnt(0)
v_readfirstlane_b32 s44, v5
s_nop 0
s_cmp_lg_u32 s44, 0
s_cbranch_scc1 WD_2
s_sleep 1
s_sub_u32 s79, s79, 1
s_cbranch_scc0 W_1
s_branch L_DONE
WD_2:
ds_read_b128 v[120:123], v10 offset:256
ds_read_b128 v[12:15], v10 offset:384
ds_read_b32 v10, v11 offset:512
v_mov_b32 v11, 0
s_waitcnt vmcnt(10) lgkmcnt(0)
v_perm_b32 v124, v20, v16, s38
v_perm_b32 v125, v28, v24, s38
v_perm_b32 v126, v36, v32, s38
v_perm_b32 v127, v44, v40, s38
v_perm_b32 v4, v20, v16, s39
v_perm_b32 v5, v28, v24, s39
v_perm_b32 v6, v36, v32, s39
v_perm_b32 v7, v44, v40, s39
v_mfma_f32_16x16x32_bf16 v[88:91], v[120:123], v[124:127], 0
v_perm_b32 v124, v21, v17, s38
v_perm_b32 v125, v29, v25, s38
v_perm_b32 v126, v37, v33, s38
v_perm_b32 v127, v45, v41, s38
v_mfma_f32_16x16x32_bf16 v[92:95], v[120:123], v[4:7], 0
v_perm_b32 v4, v21, v17, s39
v_perm_b32 v5, v29, v25, s39
v_perm_b32 v6, v37, v33, s39
v_perm_b32 v7, v45, v41, s39
v_mfma_f32_16x16x32_bf16 v[96:99], v[120:123], v[124:127], 0
v_perm_b32 v124, v22, v18, s38
v_perm_b32 v125, v30, v26, s38
v_perm_b32 v126, v38, v34, s38
v_perm_b32 v127, v46, v42, s38
v_mfma_f32_16x16x32_bf16 v[100:103], v[120:123], v[4:7], 0
v_perm_b32 v4, v22, v18, s39
v_perm_b32 v5, v30, v26, s39
v_perm_b32 v6, v38, v34, s39
v_perm_b32 v7, v46, v42, s39
v_mfma_f32_16x16x32_bf16 v[104:107], v[120:123], v[124:127], 0
v_perm_b32 v124, v23, v19, s38
v_perm_b32 v125, v31, v27, s38
v_perm_b32 v126, v39, v35, s38
v_perm_b32 v127, v47, v43, s38
v_mfma_f32_16x16x32_bf16 v[108:111], v[120:123], v[4:7], 0
v_perm_b32 v4, v23, v19, s39
v_perm_b32 v5, v31, v27, s39
v_perm_b32 v6, v39, v35, s39
v_perm_b32 v7, v47, v43, s39
v_mfma_f32_16x16x32_bf16 v[112:115], v[120:123], v[124:127], 0
s_nop 0
v_mfma_f32_16x16x32_bf16 v[116:119], v[120:123], v[4:7], 0
s_waitcnt vmcnt(2)
v_perm_b32 v124, v52, v48, s38
v_perm_b32 v125, v60, v56, s38
v_perm_b32 v126, v68, v64, s38
v_perm_b32 v127, v76, v72, s38
v_perm_b32 v4, v52, v48, s39
v_perm_b32 v5, v60, v56, s39
v_perm_b32 v6, v68, v64, s39
v_perm_b32 v7, v76, v72, s39
v_mfma_f32_16x16x32_bf16 v[88:91], v[12:15], v[124:127], v[88:91]
v_perm_b32 v124, v53, v49, s38
v_perm_b32 v125, v61, v57, s38
v_perm_b32 v126, v69, v65, s38
v_perm_b32 v127, v77, v73, s38
v_mfma_f32_16x16x32_bf16 v[92:95], v[12:15], v[4:7], v[92:95]
v_perm_b32 v4, v53, v49, s39
v_perm_b32 v5, v61, v57, s39
v_perm_b32 v6, v69, v65, s39
v_perm_b32 v7, v77, v73, s39
v_mfma_f32_16x16x32_bf16 v[96:99], v[12:15], v[124:127], v[96:99]
v_perm_b32 v124, v54, v50, s38
v_perm_b32 v125, v62, v58, s38
v_perm_b32 v126, v70, v66, s38
v_perm_b32 v127, v78, v74, s38
v_mfma_f32_16x16x32_bf16 v[100:103], v[12:15], v[4:7], v[100:103]
v_perm_b32 v4, v54, v50, s39
v_perm_b32 v5, v62, v58, s39
v_perm_b32 v6, v70, v66, s39
v_perm_b32 v7, v78, v74, s39
v_mfma_f32_16x16x32_bf16 v[104:107], v[12:15], v[124:127], v[104:107]
v_perm_b32 v124, v55, v51, s38
v_perm_b32 v125, v63, v59, s38
v_perm_b32 v126, v71, v67, s38
v_perm_b32 v127, v79, v75, s38
v_mfma_f32_16x16x32_bf16 v[108:111], v[12:15], v[4:7], v[108:111]
v_perm_b32 v4, v55, v51, s39
v_perm_b32 v5, v63, v59, s39
v_perm_b32 v6, v71, v67, s39
v_perm_b32 v7, v79, v75, s39
v_mfma_f32_16x16x32_bf16 v[112:115], v[12:15], v[124:127], v[112:115]
s_nop 0
v_mfma_f32_16x16x32_bf16 v[116:119], v[12:15], v[4:7], v[116:119]
v_mov_b32 v5, 32
ds_read_b32 v125, v5
v_mov_b32 v17, 0
v_mov_b32 v19, 0
s_waitcnt vmcnt(0)
v_perm_b32 v16, v84, v80, s38
s_nop 1
v_mfma_f32_16x16x16_bf16 v[88:91], v[10:11], v[16:17], v[88:91]
v_perm_b32 v18, v84, v80, s39
s_nop 1
v_mfma_f32_16x16x16_bf16 v[92:95], v[10:11], v[18:19], v[92:95]
v_perm_b32 v16, v85, v81, s38
s_nop 1
v_mfma_f32_16x16x16_bf16 v[96:99], v[10:11], v[16:17], v[96:99]
v_perm_b32 v18, v85, v81, s39
s_nop 1
v_mfma_f32_16x16x16_bf16 v[100:103], v[10:11], v[18:19], v[100:103]
v_perm_b32 v16, v86, v82, s38
s_nop 1
v_mfma_f32_16x16x16_bf16 v[104:107], v[10:11], v[16:17], v[104:107]
v_perm_b32 v18, v86, v82, s39
s_nop 1
v_mfma_f32_16x16x16_bf16 v[108:111], v[10:11], v[18:19], v[108:111]
v_perm_b32 v16, v87, v83, s38
s_nop 1
v_mfma_f32_16x16x16_bf16 v[112:115], v[10:11], v[16:17], v[112:115]
v_perm_b32 v18, v87, v83, s39
s_nop 1
v_mfma_f32_16x16x16_bf16 v[116:119], v[10:11], v[18:19], v[116:119]
s_waitcnt lgkmcnt(0)
v_add_f32_dpp v124, v89, v88 row_ror:8 row_mask:0x1 bank_mask:0xf
v_add_f32_dpp v126, v93, v92 row_ror:8 row_mask:0x1 bank_mask:0xf
s_nop 0
v_add_f32_dpp v124, v97, v96 row_ror:8 row_mask:0x2 bank_mask:0xf
v_add_f32_dpp v126, v101, v100 row_ror:8 row_mask:0x2 bank_mask:0xf
s_nop 0
v_add_f32_dpp v124, v105, v104 row_ror:8 row_mask:0x4 bank_mask:0xf
v_add_f32_dpp v126, v109, v108 row_ror:8 row_mask:0x4 bank_mask:0xf
s_nop 0
v_add_f32_dpp v124, v113, v112 row_ror:8 row_mask:0x8 bank_mask:0xf
v_add_f32_dpp v126, v117, v116 row_ror:8 row_mask:0x8 bank_mask:0xf
v_mov_b32 v127, v125
s_mov_b32 s46, 0x00ff00ff
s_mov_b32 s47, 0x00ff00ff
s_mov_b64 exec, s[46:47]
global_store_dwordx4 v9, v[124:127], s[30:31] sc1
s_mov_b64 exec, -1
s_lshl_b32 s44, s33, 11
s_lshl_b32 s45, s34, 2
s_add_u32 s44, s44, s45
s_add_u32 s44, s44, 2031616
v_lshlrev_b32 v5, 7, v0
v_add_u32 v5, s44, v5
s_mov_b64 exec, 0xffff
global_store_dword v5, v125, s[30:31] sc1
s_mov_b64 exec, -1
v_mov_b32 v14, v125
s_cmp_lt_u32 s36, 27
s_cbranch_scc1 W0A_3
s_setprio 0
v_lshrrev_b32 v1, 4, v0
v_bfe_u32 v3, v0, 3, 1
v_and_b32 v4, 7, v0
v_mov_b32 v8, 16
W_4:
ds_read_b32 v7, v8
s_waitcnt lgkmcnt(0)
v_readfirstlane_b32 s44, v7
s_nop 0
s_cmp_ge_u32 s44, 8
s_cbranch_scc1 WD_5
s_sleep 1
s_sub_u32 s79, s79, 1
s_cbranch_scc0 W_4
s_branch L_DONE
WD_5:
s_mov_b32 s51, 6
s_mov_b32 s55, 0
v_lshlrev_b32 v5, 5, v3
v_lshl_add_u32 v5, v1, 3, v5
s_lshl_b32 s44, s42, 6
v_add_u32 v6, s44, v5
v_mul_u32_u24 v6, 1152, v6
v_lshl_add_u32 v6, v4, 4, v6
s_lshl_b32 s44, s51, 7
v_add_u32 v6, s44, v6
v_add_u32 v7, 4608, v6
global_load_dwordx4 v[16:19], v6, s[16:17] offset:0 nt
global_load_dwordx4 v[20:23], v6, s[16:17] offset:1152 nt
global_load_dwordx4 v[24:27], v6, s[16:17] offset:2304 nt
global_load_dwordx4 v[28:31], v6, s[16:17] offset:3456 nt
global_load_dwordx4 v[32:35], v7, s[16:17] offset:0 nt
global_load_dwordx4 v[36:39], v7, s[16:17] offset:1152 nt
global_load_dwordx4 v[40:43], v7, s[16:17] offset:2304 nt
global_load_dwordx4 v[44:47], v7, s[16:17] offset:3456 nt
s_mul_i32 s58, s42, 4608
s_lshl_b32 s44, s51, 9
s_add_u32 s58, s58, s44
s_add_u32 s58, s58, 1441792
s_mov_b32 s56, 20
s_mov_b32 s57, 2048
s_branch L_T2_16
W0A_3:
s_cmp_ge_u32 s36, 27
s_cbranch_scc1 L_DONE
s_mul_i32 s45, s40, 3072
s_add_u32 s45, s45, 786432
v_lshlrev_b32 v7, 4, v0
v_add_u32 v7, s45, v7
v_readfirstlane_b32 s66, v14
s_mul_i32 s44, s40, 3
s_add_u32 s44, s44, s41
s_lshl_b32 s44, s44, 7
s_add_u32 s44, s44, 1966080
s_add_u32 s64, s30, s44
s_addc_u32 s65, s31, 0
s_mov_b32 s78, 4000
HT_6:
s_load_dwordx4 s[48:51], s[64:65], 0 glc
s_waitcnt lgkmcnt(0)
s_xor_b32 s48, s48, s66
s_xor_b32 s49, s49, s66
s_xor_b32 s50, s50, s66
s_or_b32 s48, s48, s49
s_or_b32 s48, s48, s50
s_cbranch_scc0 HTOK_7
s_sleep 2
s_sub_u32 s78, s78, 1
s_cbranch_scc0 HT_6
HTOK_7:
L_HSW:
global_load_dwordx4 v[16:19], v7, s[30:31] offset:0 sc1
global_load_dwordx4 v[20:23], v7, s[30:31] offset:1024 sc1
global_load_dwordx4 v[24:27], v7, s[30:31] offset:2048 sc1
s_waitcnt vmcnt(0)
v_xor_b32 v53, v14, v17
v_xor_b32 v54, v14, v19
v_or_b32 v52, v53, v54
v_xor_b32 v53, v14, v21
v_xor_b32 v54, v14, v23
v_or3_b32 v52, v52, v53, v54
v_xor_b32 v53, v14, v25
v_xor_b32 v54, v14, v27
v_or3_b32 v52, v52, v53, v54
v_cmp_ne_u32 vcc, 0, v52
s_cbranch_vccz OK_8
s_sub_u32 s79, s79, 1
s_cbranch_scc0 L_HSW
s_branch L_DONE
OK_8:
v_add_f32 v16, v16, v20
v_add_f32 v18, v18, v22
v_add_f32 v16, v16, v24
v_add_f32 v18, v18, v26
v_cvt_pk_bf16_f32 v16, v16, v16
v_lshlrev_b32 v16, 16, v16
v_cvt_pk_bf16_f32 v18, v18, v18
v_lshlrev_b32 v18, 16, v18
v_mul_f32 v20, 0xbfb8aa3b, v16
v_exp_f32 v20, v20
s_nop 0
v_add_f32 v20, 1.0, v20
v_rcp_f32 v20, v20
s_nop 0
v_mul_f32 v16, v16, v20
v_cvt_pk_bf16_f32 v16, v16, v16
v_lshlrev_b32 v16, 16, v16
v_mul_f32 v16, v16, v18
v_cvt_pk_bf16_f32 v16, v16, v16
v_lshlrev_b32 v9, 1, v0
ds_write_b16 v9, v16 offset:2176
s_waitcnt lgkmcnt(0)
v_mov_b32 v6, 24
v_mov_b32 v5, 1
ds_write_b32 v6, v5
s_branch L_DONE
L_W1:
v_lshlrev_b32 v5, 4, v0
v_mov_b32 v20, 0
v_mov_b32 v21, 0
v_mov_b32 v22, 0
v_mov_b32 v23, 0
s_waitcnt lgkmcnt(0)
global_load_dwordx4 v[16:19], v5, s[8:9]
s_mov_b64 exec, 0xff
global_load_dwordx4 v[20:23], v5, s[8:9] offset:1024
s_mov_b64 exec, -1
s_load_dword s48, s[30:31], 0
s_barrier
s_waitcnt vmcnt(0)
v_lshlrev_b32 v24, 16, v16
v_and_b32 v25, 0xffff0000, v16
v_lshlrev_b32 v26, 16, v17
v_and_b32 v27, 0xffff0000, v17
v_lshlrev_b32 v28, 16, v18
v_and_b32 v29, 0xffff0000, v18
v_lshlrev_b32 v30, 16, v19
v_and_b32 v31, 0xffff0000, v19
v_lshlrev_b32 v32, 16, v20
v_and_b32 v33, 0xffff0000, v20
v_lshlrev_b32 v34, 16, v21
v_and_b32 v35, 0xffff0000, v21
v_lshlrev_b32 v36, 16, v22
v_and_b32 v37, 0xffff0000, v22
v_lshlrev_b32 v38, 16, v23
v_and_b32 v39, 0xffff0000, v23
v_add_f32 v40, v24, v25
v_add_f32 v40, v40, v26
v_add_f32 v40, v40, v27
v_add_f32 v40, v40, v28
v_add_f32 v40, v40, v29
v_add_f32 v40, v40, v30
v_add_f32 v40, v40, v31
v_add_f32 v40, v40, v32
v_add_f32 v40, v40, v33
v_add_f32 v40, v40, v34
v_add_f32 v40, v40, v35
v_add_f32 v40, v40, v36
v_add_f32 v40, v40, v37
v_add_f32 v40, v40, v38
v_add_f32 v40, v40, v39
s_nop 1
v_add_f32_dpp v40, v40, v40 row_ror:8 row_mask:0xf bank_mask:0xf
s_nop 1
v_add_f32_dpp v40, v40, v40 row_ror:4 row_mask:0xf bank_mask:0xf
s_nop 1
v_add_f32_dpp v40, v40, v40 row_ror:2 row_mask:0xf bank_mask:0xf
s_nop 1
v_add_f32_dpp v40, v40, v40 row_ror:1 row_mask:0xf bank_mask:0xf
v_mov_b32 v41, v40
s_nop 1
v_permlane16_swap_b32 v40, v41
v_add_f32 v40, v40, v41
v_mov_b32 v41, v40
s_nop 1
v_permlane32_swap_b32 v40, v41
v_add_f32 v40, v40, v41
v_mul_f32 v40, 0x3ae38e39, v40
v_sub_f32 v42, v24, v40
v_mul_f32 v41, v42, v42
v_sub_f32 v42, v25, v40
v_fmac_f32 v41, v42, v42
v_sub_f32 v42, v26, v40
v_fmac_f32 v41, v42, v42
v_sub_f32 v42, v27, v40
v_fmac_f32 v41, v42, v42
v_sub_f32 v42, v28, v40
v_fmac_f32 v41, v42, v42
v_sub_f32 v42, v29, v40
v_fmac_f32 v41, v42, v42
v_sub_f32 v42, v30, v40
v_fmac_f32 v41, v42, v42
v_sub_f32 v42, v31, v40
v_fmac_f32 v41, v42, v42
s_mov_b64 exec, 0xff
v_sub_f32 v42, v32, v40
v_fmac_f32 v41, v42, v42
v_sub_f32 v42, v33, v40
v_fmac_f32 v41, v42, v42
v_sub_f32 v42, v34, v40
v_fmac_f32 v41, v42, v42
v_sub_f32 v42, v35, v40
v_fmac_f32 v41, v42, v42
v_sub_f32 v42, v36, v40
v_fmac_f32 v41, v42, v42
v_sub_f32 v42, v37, v40
v_fmac_f32 v41, v42, v42
v_sub_f32 v42, v38, v40
v_fmac_f32 v41, v42, v42
v_sub_f32 v42, v39, v40
v_fmac_f32 v41, v42, v42
s_mov_b64 exec, -1
s_nop 0
v_add_f32_dpp v41, v41, v41 row_ror:8 row_mask:0xf bank_mask:0xf
s_nop 1
v_add_f32_dpp v41, v41, v41 row_ror:4 row_mask:0xf bank_mask:0xf
s_nop 1
v_add_f32_dpp v41, v41, v41 row_ror:2 row_mask:0xf bank_mask:0xf
s_nop 1
v_add_f32_dpp v41, v41, v41 row_ror:1 row_mask:0xf bank_mask:0xf
v_mov_b32 v42, v41
s_nop 1
v_permlane16_swap_b32 v41, v42
v_add_f32 v41, v41, v42
v_mov_b32 v42, v41
s_nop 1
v_permlane32_swap_b32 v41, v42
v_add_f32 v41, v41, v42
v_mul_f32 v41, 0x3ae38e39, v41
v_cvt_pk_bf16_f32 v40, v40, v40
v_lshlrev_b32 v40, 16, v40
v_cvt_pk_bf16_f32 v41, v41, v41
v_lshlrev_b32 v41, 16, v41
v_add_f32 v41, 0x3727c5ac, v41
v_cvt_pk_bf16_f32 v41, v41, v41
v_lshlrev_b32 v41, 16, v41
v_sqrt_f32 v41, v41
s_nop 0
v_cvt_pk_bf16_f32 v41, v41, v41
v_lshlrev_b32 v41, 16, v41
v_rcp_f32 v41, v41
v_sub_f32 v24, v24, v40
v_sub_f32 v25, v25, v40
v_cvt_pk_bf16_f32 v24, v24, v25
v_and_b32 v25, 0xffff0000, v24
v_lshlrev_b32 v24, 16, v24
v_mul_f32 v24, v24, v41
v_mul_f32 v25, v25, v41
v_cvt_pk_bf16_f32 v16, v24, v25
v_sub_f32 v26, v26, v40
v_sub_f32 v27, v27, v40
v_cvt_pk_bf16_f32 v26, v26, v27
v_and_b32 v27, 0xffff0000, v26
v_lshlrev_b32 v26, 16, v26
v_mul_f32 v26, v26, v41
v_mul_f32 v27, v27, v41
v_cvt_pk_bf16_f32 v17, v26, v27
v_sub_f32 v28, v28, v40
v_sub_f32 v29, v29, v40
v_cvt_pk_bf16_f32 v28, v28, v29
v_and_b32 v29, 0xffff0000, v28
v_lshlrev_b32 v28, 16, v28
v_mul_f32 v28, v28, v41
v_mul_f32 v29, v29, v41
v_cvt_pk_bf16_f32 v18, v28, v29
v_sub_f32 v30, v30, v40
v_sub_f32 v31, v31, v40
v_cvt_pk_bf16_f32 v30, v30, v31
v_and_b32 v31, 0xffff0000, v30
v_lshlrev_b32 v30, 16, v30
v_mul_f32 v30, v30, v41
v_mul_f32 v31, v31, v41
v_cvt_pk_bf16_f32 v19, v30, v31
v_sub_f32 v32, v32, v40
v_sub_f32 v33, v33, v40
v_cvt_pk_bf16_f32 v32, v32, v33
v_and_b32 v33, 0xffff0000, v32
v_lshlrev_b32 v32, 16, v32
v_mul_f32 v32, v32, v41
v_mul_f32 v33, v33, v41
v_cvt_pk_bf16_f32 v20, v32, v33
v_sub_f32 v34, v34, v40
v_sub_f32 v35, v35, v40
v_cvt_pk_bf16_f32 v34, v34, v35
v_and_b32 v35, 0xffff0000, v34
v_lshlrev_b32 v34, 16, v34
v_mul_f32 v34, v34, v41
v_mul_f32 v35, v35, v41
v_cvt_pk_bf16_f32 v21, v34, v35
v_sub_f32 v36, v36, v40
v_sub_f32 v37, v37, v40
v_cvt_pk_bf16_f32 v36, v36, v37
v_and_b32 v37, 0xffff0000, v36
v_lshlrev_b32 v36, 16, v36
v_mul_f32 v36, v36, v41
v_mul_f32 v37, v37, v41
v_cvt_pk_bf16_f32 v22, v36, v37
v_sub_f32 v38, v38, v40
v_sub_f32 v39, v39, v40
v_cvt_pk_bf16_f32 v38, v38, v39
v_and_b32 v39, 0xffff0000, v38
v_lshlrev_b32 v38, 16, v38
v_mul_f32 v38, v38, v41
v_mul_f32 v39, v39, v41
v_cvt_pk_bf16_f32 v23, v38, v39
ds_write_b128 v5, v[16:19] offset:256
s_mov_b64 exec, 0xff
ds_write_b128 v5, v[20:23] offset:1280
s_mov_b64 exec, -1
s_waitcnt lgkmcnt(0)
s_add_u32 s48, s48, 2654435769
v_mov_b32 v14, s48
s_mov_b32 s66, s48
v_mov_b32 v6, 32
ds_write_b32 v6, v14
s_waitcnt lgkmcnt(0)
v_mov_b32 v6, 0
v_mov_b32 v5, 1
ds_write_b32 v6, v5
s_lshl_b32 s45, s33, 13
s_add_u32 s45, s45, 65536
v_lshlrev_b32 v7, 4, v0
v_add_u32 v7, s45, v7
v_add_u32 v8, 4096, v7
s_lshl_b32 s44, s33, 4
s_add_u32 s44, s44, s34
s_lshl_b32 s44, s44, 7
s_add_u32 s44, s44, 2031616
s_add_u32 s64, s30, s44
s_addc_u32 s65, s31, 0
s_mov_b32 s67, s66
s_mov_b32 s78, 4000
QT_9:
s_load_dwordx16 s[48:63], s[64:65], 0 glc
s_waitcnt lgkmcnt(0)
s_xor_b64 s[48:49], s[48:49], s[66:67]
s_xor_b64 s[50:51], s[50:51], s[66:67]
s_xor_b64 s[52:53], s[52:53], s[66:67]
s_xor_b64 s[54:55], s[54:55], s[66:67]
s_xor_b64 s[56:57], s[56:57], s[66:67]
s_xor_b64 s[58:59], s[58:59], s[66:67]
s_xor_b64 s[60:61], s[60:61], s[66:67]
s_xor_b64 s[62:63], s[62:63], s[66:67]
s_or_b64 s[48:49], s[48:49], s[50:51]
s_or_b64 s[48:49], s[48:49], s[52:53]
s_or_b64 s[48:49], s[48:49], s[54:55]
s_or_b64 s[48:49], s[48:49], s[56:57]
s_or_b64 s[48:49], s[48:49], s[58:59]
s_or_b64 s[48:49], s[48:49], s[60:61]
s_or_b64 s[48:49], s[48:49], s[62:63]
s_cbranch_scc0 QTOK_10
s_sub_u32 s78, s78, 1
s_cbranch_scc0 QT_9
QTOK_10:
L_QSW:
global_load_dwordx4 v[16:19], v7, s[30:31] offset:0 sc1
global_load_dwordx4 v[20:23], v7, s[30:31] offset:1024 sc1
global_load_dwordx4 v[24:27], v7, s[30:31] offset:2048 sc1
global_load_dwordx4 v[28:31], v7, s[30:31] offset:3072 sc1
global_load_dwordx4 v[32:35], v8, s[30:31] offset:0 sc1
global_load_dwordx4 v[36:39], v8, s[30:31] offset:1024 sc1
global_load_dwordx4 v[40:43], v8, s[30:31] offset:2048 sc1
global_load_dwordx4 v[44:47], v8, s[30:31] offset:3072 sc1
s_waitcnt vmcnt(0)
v_xor_b32 v49, v14, v17
v_xor_b32 v50, v14, v21
v_or_b32 v48, v49, v50
v_xor_b32 v49, v14, v25
v_xor_b32 v50, v14, v29
v_or3_b32 v48, v48, v49, v50
v_xor_b32 v49, v14, v33
v_xor_b32 v50, v14, v37
v_or3_b32 v48, v48, v49, v50
v_xor_b32 v49, v14, v41
v_xor_b32 v50, v14, v45
v_or3_b32 v48, v48, v49, v50
v_xor_b32 v49, v14, v19
v_xor_b32 v50, v14, v23
v_or3_b32 v48, v48, v49, v50
v_xor_b32 v49, v14, v27
v_xor_b32 v50, v14, v31
v_or3_b32 v48, v48, v49, v50
v_xor_b32 v49, v14, v35
v_xor_b32 v50, v14, v39
v_or3_b32 v48, v48, v49, v50
v_xor_b32 v49, v14, v43
v_xor_b32 v50, v14, v47
v_or3_b32 v48, v48, v49, v50
v_cmp_ne_u32 vcc, 0, v48
s_cbranch_vccz OK_11
s_sub_u32 s79, s79, 1
s_cbranch_scc0 L_QSW
s_branch L_DONE
OK_11:
v_add_f32 v52, v16, v24
v_add_f32 v52, v52, v32
v_add_f32 v52, v52, v40
v_add_f32 v53, v18, v26
v_add_f32 v53, v53, v34
v_add_f32 v53, v53, v42
v_add_f32 v54, v20, v28
v_add_f32 v54, v54, v36
v_add_f32 v54, v54, v44
v_add_f32 v55, v22, v30
v_add_f32 v55, v55, v38
v_add_f32 v55, v55, v46
v_cvt_pk_bf16_f32 v52, v52, v53
v_cvt_pk_bf16_f32 v54, v54, v55
v_lshrrev_b32 v9, 5, v0
v_lshlrev_b32 v9, 7, v9
v_lshl_add_u32 v9, v4, 4, v9
v_bfe_u32 v10, v0, 3, 2
v_lshl_add_u32 v9, v10, 2, v9
ds_write_b32 v9, v52 offset:1536
ds_write_b32 v9, v54 offset:1792
s_waitcnt lgkmcnt(0)
v_mov_b32 v6, 4
v_mov_b32 v5, 1
ds_write_b32 v6, v5
L_OPH:
s_lshl_b32 s45, s42, 13
s_add_u32 s45, s45, 262144
v_lshlrev_b32 v7, 3, v0
v_add_u32 v7, s45, v7
v_add_u32 v8, 4096, v7
s_and_b32 s44, s37, 1
s_add_u32 s45, s43, 1
s_cmp_eq_u32 s37, 5
s_cselect_b32 s44, s45, s44
s_cmp_eq_u32 s37, 4
s_cselect_b32 s44, 0, s44
s_cmp_eq_u32 s37, 6
s_cselect_b32 s44, s43, s44
s_add_u32 s45, s43, 9
s_cmp_eq_u32 s37, 7
s_cselect_b32 s44, s45, s44
s_lshr_b32 s45, s42, 1
s_mul_i32 s45, s45, 18
s_add_u32 s45, s45, s44
s_lshl_b32 s45, s45, 7
s_add_u32 s45, s45, 1835008
v_lshlrev_b32 v9, 3, v2
v_add_u32 v9, s45, v9
s_add_u32 s64, s30, s45
s_addc_u32 s65, s31, 0
s_mov_b32 s78, 4000
OT_12:
s_load_dwordx16 s[48:63], s[64:65], 0 glc
s_load_dwordx16 s[8:23], s[64:65], 64 glc
s_waitcnt lgkmcnt(0)
s_xor_b32 s44, s49, s66
s_xor_b32 s45, s51, s66
s_or_b32 s44, s44, s45
s_xor_b32 s45, s53, s66
s_or_b32 s44, s44, s45
s_xor_b32 s45, s55, s66
s_or_b32 s44, s44, s45
s_xor_b32 s45, s57, s66
s_or_b32 s44, s44, s45
s_xor_b32 s45, s59, s66
s_or_b32 s44, s44, s45
s_xor_b32 s45, s61, s66
s_or_b32 s44, s44, s45
s_xor_b32 s45, s63, s66
s_or_b32 s44, s44, s45
s_xor_b32 s45, s9, s66
s_or_b32 s44, s44, s45
s_xor_b32 s45, s11, s66
s_or_b32 s44, s44, s45
s_xor_b32 s45, s13, s66
s_or_b32 s44, s44, s45
s_xor_b32 s45, s15, s66
s_or_b32 s44, s44, s45
s_xor_b32 s45, s17, s66
s_or_b32 s44, s44, s45
s_xor_b32 s45, s19, s66
s_or_b32 s44, s44, s45
s_xor_b32 s45, s21, s66
s_or_b32 s44, s44, s45
s_xor_b32 s45, s23, s66
s_or_b32 s44, s44, s45
s_cmp_eq_u32 s44, 0
s_cbranch_scc1 OTOK_13
s_sub_u32 s78, s78, 1
s_cbranch_scc0 OT_12
OTOK_13:
L_OSW:
global_load_dwordx2 v[48:49], v9, s[30:31] sc1
global_load_dwordx2 v[16:17], v7, s[30:31] offset:0 sc1
global_load_dwordx2 v[18:19], v7, s[30:31] offset:512 sc1
global_load_dwordx2 v[20:21], v7, s[30:31] offset:1024 sc1
global_load_dwordx2 v[22:23], v7, s[30:31] offset:1536 sc1
global_load_dwordx2 v[24:25], v7, s[30:31] offset:2048 sc1
global_load_dwordx2 v[26:27], v7, s[30:31] offset:2560 sc1
global_load_dwordx2 v[28:29], v7, s[30:31] offset:3072 sc1
global_load_dwordx2 v[30:31], v7, s[30:31] offset:3584 sc1
global_load_dwordx2 v[32:33], v8, s[30:31] offset:0 sc1
global_load_dwordx2 v[34:35], v8, s[30:31] offset:512 sc1
global_load_dwordx2 v[36:37], v8, s[30:31] offset:1024 sc1
global_load_dwordx2 v[38:39], v8, s[30:31] offset:1536 sc1
global_load_dwordx2 v[40:41], v8, s[30:31] offset:2048 sc1
global_load_dwordx2 v[42:43], v8, s[30:31] offset:2560 sc1
global_load_dwordx2 v[44:45], v8, s[30:31] offset:3072 sc1
global_load_dwordx2 v[46:47], v8, s[30:31] offset:3584 sc1
s_waitcnt vmcnt(0)
v_xor_b32 v53, v14, v49
v_xor_b32 v54, v14, v17
v_or_b32 v52, v53, v54
v_xor_b32 v53, v14, v19
v_xor_b32 v54, v14, v21
v_or3_b32 v52, v52, v53, v54
v_xor_b32 v53, v14, v23
v_xor_b32 v54, v14, v25
v_or3_b32 v52, v52, v53, v54
v_xor_b32 v53, v14, v27
v_xor_b32 v54, v14, v29
v_or3_b32 v52, v52, v53, v54
v_xor_b32 v53, v14, v31
v_xor_b32 v54, v14, v33
v_or3_b32 v52, v52, v53, v54
v_xor_b32 v53, v14, v35
v_xor_b32 v54, v14, v37
v_or3_b32 v52, v52, v53, v54
v_xor_b32 v53, v14, v39
v_xor_b32 v54, v14, v41
v_or3_b32 v52, v52, v53, v54
v_xor_b32 v53, v14, v43
v_xor_b32 v54, v14, v45
v_or3_b32 v52, v52, v53, v54
v_xor_b32 v53, v14, v47
v_or_b32 v52, v52, v53
v_cmp_ne_u32 vcc, 0, v52
s_cbranch_vccz OK_14
s_sub_u32 s79, s79, 1
s_cbranch_scc0 L_OSW
s_branch L_DONE
OK_14:
v_mov_b32 v52, v48
s_nop 1
v_max_f32_dpp v52, v52, v52 row_ror:8 row_mask:0xf bank_mask:0xf
s_nop 1
v_max_f32_dpp v52, v52, v52 row_ror:4 row_mask:0xf bank_mask:0xf
s_nop 1
v_max_f32_dpp v52, v52, v52 row_ror:2 row_mask:0xf bank_mask:0xf
s_nop 1
v_max_f32_dpp v52, v52, v52 row_ror:1 row_mask:0xf bank_mask:0xf
v_sub_f32 v52, v48, v52
v_exp_f32 v52, v52
s_nop 0
v_mov_b32 v53, v52
s_nop 1
v_add_f32_dpp v53, v53, v53 row_ror:8 row_mask:0xf bank_mask:0xf
s_nop 1
v_add_f32_dpp v53, v53, v53 row_ror:4 row_mask:0xf bank_mask:0xf
s_nop 1
v_add_f32_dpp v53, v53, v53 row_ror:2 row_mask:0xf bank_mask:0xf
s_nop 1
v_add_f32_dpp v53, v53, v53 row_ror:1 row_mask:0xf bank_mask:0xf
v_rcp_f32 v53, v53
s_nop 0
v_mul_f32 v52, v52, v53
s_nop 0
v_readlane_b32 s48, v52, 0
v_readlane_b32 s49, v52, 1
v_readlane_b32 s50, v52, 2
v_readlane_b32 s51, v52, 3
v_readlane_b32 s52, v52, 4
v_readlane_b32 s53, v52, 5
v_readlane_b32 s54, v52, 6
v_readlane_b32 s55, v52, 7
v_readlane_b32 s56, v52, 8
v_readlane_b32 s57, v52, 9
v_readlane_b32 s58, v52, 10
v_readlane_b32 s59, v52, 11
v_readlane_b32 s60, v52, 12
v_readlane_b32 s61, v52, 13
v_readlane_b32 s62, v52, 14
v_readlane_b32 s63, v52, 15
v_mul_f32 v55, s48, v16
v_fmac_f32 v55, s49, v18
v_fmac_f32 v55, s50, v20
v_fmac_f32 v55, s51, v22
v_fmac_f32 v55, s52, v24
v_fmac_f32 v55, s53, v26
v_fmac_f32 v55, s54, v28
v_fmac_f32 v55, s55, v30
v_fmac_f32 v55, s56, v32
v_fmac_f32 v55, s57, v34
v_fmac_f32 v55, s58, v36
v_fmac_f32 v55, s59, v38
v_fmac_f32 v55, s60, v40
v_fmac_f32 v55, s61, v42
v_fmac_f32 v55, s62, v44
v_fmac_f32 v55, s63, v46
v_cvt_pk_bf16_f32 v55, v55, v55
v_lshrrev_b32 v9, 3, v0
v_lshl_add_u32 v9, v4, 3, v9
v_lshlrev_b32 v9, 1, v9
ds_write_b16 v9, v55 offset:2048
s_waitcnt lgkmcnt(0)
v_mov_b32 v6, 20
v_mov_b32 v5, 1
ds_write_b32 v6, v5
s_branch L_DONE
L_GV:
s_sub_u32 s50, s32, 2
s_cmp_ge_u32 s36, 27
s_cbranch_scc1 L_GVB
v_mov_b32 v8, 16
W_15:
ds_read_b32 v7, v8
s_waitcnt lgkmcnt(0)
v_readfirstlane_b32 s44, v7
s_nop 0
s_cmp_ge_u32 s44, 6
s_cbranch_scc1 WD_16
s_sleep 1
s_sub_u32 s79, s79, 1
s_cbranch_scc0 W_15
s_branch L_DONE
WD_16:
v_lshlrev_b32 v5, 5, v3
v_lshl_add_u32 v5, v1, 3, v5
s_lshr_b32 s44, s50, 1
s_mul_i32 s45, s41, 3
s_add_u32 s45, s45, s44
s_lshl_b32 s51, s45, 6
v_add_u32 v5, s51, v5
s_mov_b32 s44, 9216
v_mul_lo_u32 v9, v5, s44
v_lshl_add_u32 v9, v4, 4, v9
s_lshl_b32 s44, s40, 7
v_add_u32 v9, s44, v9
s_bitcmp1_b32 s50, 0
s_cselect_b32 s48, s22, s20
s_cselect_b32 s49, s23, s21
global_load_dwordx4 v[16:19], v9, s[48:49] nt
v_add_u32 v9, 9216, v9
global_load_dwordx4 v[20:23], v9, s[48:49] nt
v_add_u32 v9, 9216, v9
global_load_dwordx4 v[24:27], v9, s[48:49] nt
v_add_u32 v9, 9216, v9
s_waitcnt vmcnt(2)
global_load_dwordx4 v[28:31], v9, s[48:49] nt
v_add_u32 v9, 9216, v9
s_waitcnt vmcnt(2)
global_load_dwordx4 v[32:35], v9, s[48:49] nt
v_add_u32 v9, 9216, v9
s_waitcnt vmcnt(2)
global_load_dwordx4 v[36:39], v9, s[48:49] nt
v_add_u32 v9, 9216, v9
s_waitcnt vmcnt(2)
global_load_dwordx4 v[40:43], v9, s[48:49] nt
v_add_u32 v9, 9216, v9
s_waitcnt vmcnt(2)
global_load_dwordx4 v[44:47], v9, s[48:49] nt
v_and_b32 v10, 1, v0
v_lshlrev_b32 v10, 5, v10
v_lshl_add_u32 v10, v1, 3, v10
v_add_u32 v10, s51, v10
v_lshlrev_b32 v10, 1, v10
v_mov_b32 v11, v10
v_mov_b32 v6, 44
v_mov_b32 v5, 1
s_mov_b64 exec, 1
ds_add_u32 v6, v5
s_mov_b64 exec, -1
s_mov_b32 s55, 0
s_cmp_le_u32 s50, 3
s_cselect_b32 s55, 1, 0
s_cmp_eq_u32 s55, 0
s_cbranch_scc1 SK_17
v_mov_b32 v8, 44
W_18:
ds_read_b32 v7, v8
s_waitcnt lgkmcnt(0)
v_readfirstlane_b32 s44, v7
s_nop 0
s_cmp_ge_u32 s44, 6
s_cbranch_scc1 WD_19
s_sleep 1
s_sub_u32 s79, s79, 1
s_cbranch_scc0 W_18
s_branch L_DONE
WD_19:
s_mov_b32 s55, 0
s_cmp_gt_u32 s50, 3
s_cbranch_scc1 S2_20
s_mov_b32 s55, 1
s_cmp_eq_u32 s50, 3
s_cbranch_scc1 S2WO_21
s_mul_i32 s51, s41, 3
s_add_u32 s51, s51, s50
v_lshlrev_b32 v5, 5, v3
v_lshl_add_u32 v5, v1, 3, v5
s_lshl_b32 s44, s40, 6
v_add_u32 v6, s44, v5
v_mul_u32_u24 v6, 1152, v6
v_lshl_add_u32 v6, v4, 4, v6
s_lshl_b32 s44, s51, 7
v_add_u32 v6, s44, v6
v_add_u32 v7, 4608, v6
global_load_dwordx4 v[48:51], v6, s[24:25] offset:0 nt
global_load_dwordx4 v[52:55], v6, s[24:25] offset:1152 nt
global_load_dwordx4 v[56:59], v6, s[24:25] offset:2304 nt
global_load_dwordx4 v[60:63], v6, s[24:25] offset:3456 nt
global_load_dwordx4 v[64:67], v7, s[24:25] offset:0 nt
global_load_dwordx4 v[68:71], v7, s[24:25] offset:1152 nt
global_load_dwordx4 v[72:75], v7, s[24:25] offset:2304 nt
global_load_dwordx4 v[76:79], v7, s[24:25] offset:3456 nt
s_mul_i32 s54, s40, 4608
s_lshl_b32 s44, s51, 9
s_add_u32 s54, s54, s44
s_add_u32 s54, s54, 1048576
s_mov_b32 s52, 24
s_mov_b32 s53, 2176
s_branch S2_20
S2WO_21:
s_mov_b32 s51, s43
v_lshlrev_b32 v5, 5, v3
v_lshl_add_u32 v5, v1, 3, v5
s_lshl_b32 s44, s42, 6
v_add_u32 v6, s44, v5
v_mul_u32_u24 v6, 1152, v6
v_lshl_add_u32 v6, v4, 4, v6
s_lshl_b32 s44, s51, 7
v_add_u32 v6, s44, v6
v_add_u32 v7, 4608, v6
global_load_dwordx4 v[48:51], v6, s[16:17] offset:0 nt
global_load_dwordx4 v[52:55], v6, s[16:17] offset:1152 nt
global_load_dwordx4 v[56:59], v6, s[16:17] offset:2304 nt
global_load_dwordx4 v[60:63], v6, s[16:17] offset:3456 nt
global_load_dwordx4 v[64:67], v7, s[16:17] offset:0 nt
global_load_dwordx4 v[68:71], v7, s[16:17] offset:1152 nt
global_load_dwordx4 v[72:75], v7, s[16:17] offset:2304 nt
global_load_dwordx4 v[76:79], v7, s[16:17] offset:3456 nt
s_mul_i32 s54, s42, 4608
s_lshl_b32 s44, s51, 9
s_add_u32 s54, s54, s44
s_add_u32 s54, s54, 1441792
s_mov_b32 s52, 20
s_mov_b32 s53, 2048
S2_20:
SK_17:
v_mov_b32 v8, 0
W_22:
ds_read_b32 v7, v8
s_waitcnt lgkmcnt(0)
v_readfirstlane_b32 s44, v7
s_nop 0
s_cmp_lg_u32 s44, 0
s_cbranch_scc1 WD_23
s_sleep 1
s_sub_u32 s79, s79, 1
s_cbranch_scc0 W_22
s_branch L_DONE
WD_23:
ds_read_b128 v[120:123], v11 offset:256
s_cmp_eq_u32 s55, 0
s_cbranch_scc1 N2_24
s_waitcnt vmcnt(8) lgkmcnt(0)
s_branch L_GUGO
N2_24:
s_waitcnt vmcnt(0) lgkmcnt(0)
L_GUGO:
s_setprio 3
v_perm_b32 v112, v20, v16, s38
v_perm_b32 v113, v28, v24, s38
v_perm_b32 v114, v36, v32, s38
v_perm_b32 v115, v44, v40, s38
v_perm_b32 v116, v20, v16, s39
v_perm_b32 v117, v28, v24, s39
v_perm_b32 v118, v36, v32, s39
v_perm_b32 v119, v44, v40, s39
v_mfma_f32_16x16x32_bf16 v[80:83], v[120:123], v[112:115], 0
v_perm_b32 v112, v21, v17, s38
v_perm_b32 v113, v29, v25, s38
v_perm_b32 v114, v37, v33, s38
v_perm_b32 v115, v45, v41, s38
v_mfma_f32_16x16x32_bf16 v[84:87], v[120:123], v[116:119], 0
v_perm_b32 v116, v21, v17, s39
v_perm_b32 v117, v29, v25, s39
v_perm_b32 v118, v37, v33, s39
v_perm_b32 v119, v45, v41, s39
v_mfma_f32_16x16x32_bf16 v[88:91], v[120:123], v[112:115], 0
v_perm_b32 v112, v22, v18, s38
v_perm_b32 v113, v30, v26, s38
v_perm_b32 v114, v38, v34, s38
v_perm_b32 v115, v46, v42, s38
v_mfma_f32_16x16x32_bf16 v[92:95], v[120:123], v[116:119], 0
v_perm_b32 v116, v22, v18, s39
v_perm_b32 v117, v30, v26, s39
v_perm_b32 v118, v38, v34, s39
v_perm_b32 v119, v46, v42, s39
v_mfma_f32_16x16x32_bf16 v[96:99], v[120:123], v[112:115], 0
v_perm_b32 v112, v23, v19, s38
v_perm_b32 v113, v31, v27, s38
v_perm_b32 v114, v39, v35, s38
v_perm_b32 v115, v47, v43, s38
v_mfma_f32_16x16x32_bf16 v[100:103], v[120:123], v[116:119], 0
v_perm_b32 v116, v23, v19, s39
v_perm_b32 v117, v31, v27, s39
v_perm_b32 v118, v39, v35, s39
v_perm_b32 v119, v47, v43, s39
v_mfma_f32_16x16x32_bf16 v[104:107], v[120:123], v[112:115], 0
s_nop 0
v_mfma_f32_16x16x32_bf16 v[108:111], v[120:123], v[116:119], 0
v_add_f32_dpp v16, v81, v80 row_ror:8 row_mask:0xf bank_mask:0xf
v_add_f32_dpp v17, v85, v84 row_ror:8 row_mask:0xf bank_mask:0xf
v_add_f32_dpp v18, v89, v88 row_ror:8 row_mask:0xf bank_mask:0xf
v_add_f32_dpp v19, v93, v92 row_ror:8 row_mask:0xf bank_mask:0xf
v_add_f32_dpp v20, v97, v96 row_ror:8 row_mask:0xf bank_mask:0xf
v_add_f32_dpp v21, v101, v100 row_ror:8 row_mask:0xf bank_mask:0xf
v_add_f32_dpp v22, v105, v104 row_ror:8 row_mask:0xf bank_mask:0xf
s_nop 0
v_add_f32_dpp v23, v109, v108 row_ror:8 row_mask:0xf bank_mask:0xf
s_lshl_b32 s44, s50, 8
v_lshlrev_b32 v6, 5, v4
v_add_u32 v6, s44, v6
s_mov_b64 exec, 0xff
ds_write_b128 v6, v[16:19] offset:2304
ds_write_b128 v6, v[20:23] offset:2320
s_mov_b64 exec, -1
s_waitcnt lgkmcnt(0)
v_mov_b32 v6, 12
v_mov_b32 v5, 1
s_mov_b64 exec, 1
ds_add_rtn_u32 v5, v6, v5
s_waitcnt lgkmcnt(0)
v_readfirstlane_b32 s44, v5
s_mov_b64 exec, -1
s_cmp_lg_u32 s44, 5
s_cbranch_scc1 L_GUX
v_lshlrev_b32 v6, 2, v0
ds_read_b32 v16, v6 offset:2304
ds_read_b32 v17, v6 offset:2560
ds_read_b32 v18, v6 offset:2816
ds_read_b32 v19, v6 offset:3072
ds_read_b32 v20, v6 offset:3328
ds_read_b32 v21, v6 offset:3584
v_mov_b32 v7, 32
ds_read_b32 v25, v7
s_mul_i32 s44, s40, 3
s_add_u32 s44, s44, s41
s_lshl_b32 s44, s44, 10
s_add_u32 s44, s44, 786432
v_lshlrev_b32 v6, 4, v0
v_add_u32 v6, s44, v6
s_waitcnt lgkmcnt(0)
v_add_f32 v24, v16, v18
v_add_f32 v26, v17, v19
v_add_f32 v24, v24, v20
v_add_f32 v26, v26, v21
v_mov_b32 v27, v25
global_store_dwordx4 v6, v[24:27], s[30:31] sc1
s_mul_i32 s44, s40, 384
s_lshl_b32 s45, s41, 2
s_add_u32 s44, s44, s45
s_add_u32 s44, s44, 1966080
v_lshlrev_b32 v6, 7, v0
v_add_u32 v6, s44, v6
s_mov_b64 exec, 7
global_store_dword v6, v25, s[30:31] sc1
s_mov_b64 exec, -1
s_waitcnt lgkmcnt(0)
v_mov_b32 v6, 48
v_mov_b32 v5, 1
ds_write_b32 v6, v5
L_GUX:
s_setprio 0
s_cmp_eq_u32 s55, 0
s_cbranch_scc1 L_DONE
s_branch L_T2_48
L_GVB:
s_mov_b32 s55, 0
v_mov_b32 v6, 44
v_mov_b32 v5, 1
s_mov_b64 exec, 1
ds_add_u32 v6, v5
s_mov_b64 exec, -1
v_mov_b32 v8, 16
W_25:
ds_read_b32 v7, v8
s_waitcnt lgkmcnt(0)
v_readfirstlane_b32 s44, v7
s_nop 0
s_cmp_ge_u32 s44, 8
s_cbranch_scc1 WD_26
s_sleep 1
s_sub_u32 s79, s79, 1
s_cbranch_scc0 W_25
s_branch L_DONE
WD_26:
v_lshlrev_b32 v5, 5, v3
v_lshl_add_u32 v5, v1, 3, v5
s_lshl_b32 s44, s42, 6
v_add_u32 v6, s44, v5
v_mul_u32_u24 v6, 1152, v6
v_lshl_add_u32 v6, v4, 4, v6
s_lshl_b32 s44, s50, 7
v_add_u32 v6, s44, v6
v_add_u32 v7, 4608, v6
global_load_dwordx4 v[48:51], v6, s[16:17] offset:0 nt
global_load_dwordx4 v[52:55], v6, s[16:17] offset:1152 nt
global_load_dwordx4 v[56:59], v6, s[16:17] offset:2304 nt
global_load_dwordx4 v[60:63], v6, s[16:17] offset:3456 nt
global_load_dwordx4 v[64:67], v7, s[16:17] offset:0 nt
global_load_dwordx4 v[68:71], v7, s[16:17] offset:1152 nt
global_load_dwordx4 v[72:75], v7, s[16:17] offset:2304 nt
global_load_dwordx4 v[76:79], v7, s[16:17] offset:3456 nt
s_mul_i32 s54, s42, 4608
s_lshl_b32 s44, s50, 9
s_add_u32 s54, s54, s44
s_add_u32 s54, s54, 1441792
s_mov_b32 s52, 20
s_mov_b32 s53, 2048
B1_27:
s_branch B2_28
s_cmp_gt_u32 s50, 2
s_cbranch_scc1 B2_28
s_add_u32 s51, s50, 6
s_cmp_ge_u32 s51, 9
s_cbranch_scc1 B2_28
v_lshlrev_b32 v5, 5, v3
v_lshl_add_u32 v5, v1, 3, v5
s_lshl_b32 s44, s42, 6
v_add_u32 v6, s44, v5
v_mul_u32_u24 v6, 1152, v6
v_lshl_add_u32 v6, v4, 4, v6
s_lshl_b32 s44, s51, 7
v_add_u32 v6, s44, v6
v_add_u32 v7, 4608, v6
global_load_dwordx4 v[16:19], v6, s[16:17] offset:0 nt
global_load_dwordx4 v[20:23], v6, s[16:17] offset:1152 nt
global_load_dwordx4 v[24:27], v6, s[16:17] offset:2304 nt
global_load_dwordx4 v[28:31], v6, s[16:17] offset:3456 nt
global_load_dwordx4 v[32:35], v7, s[16:17] offset:0 nt
global_load_dwordx4 v[36:39], v7, s[16:17] offset:1152 nt
global_load_dwordx4 v[40:43], v7, s[16:17] offset:2304 nt
global_load_dwordx4 v[44:47], v7, s[16:17] offset:3456 nt
s_mul_i32 s58, s42, 4608
s_lshl_b32 s44, s51, 9
s_add_u32 s58, s58, s44
s_add_u32 s58, s58, 1441792
s_mov_b32 s56, 20
s_mov_b32 s57, 2048
B2_28:
L_T2_48:
v_and_b32 v5, 1, v0
v_lshlrev_b32 v5, 5, v5
v_lshl_add_u32 v5, v1, 3, v5
v_lshlrev_b32 v10, 1, v5
v_add_u32 v10, s53, v10
v_lshlrev_b32 v9, 7, v1
v_lshl_add_u32 v9, v4, 4, v9
v_add_u32 v9, s54, v9
v_mov_b32 v6, s52
s_waitcnt vmcnt(0)
v_perm_b32 v80, v52, v48, s38
v_perm_b32 v81, v60, v56, s38
v_perm_b32 v82, v68, v64, s38
v_perm_b32 v83, v76, v72, s38
v_perm_b32 v84, v52, v48, s39
v_perm_b32 v85, v60, v56, s39
v_perm_b32 v86, v68, v64, s39
v_perm_b32 v87, v76, v72, s39
v_perm_b32 v88, v53, v49, s38
v_perm_b32 v89, v61, v57, s38
v_perm_b32 v90, v69, v65, s38
v_perm_b32 v91, v77, v73, s38
v_perm_b32 v92, v53, v49, s39
v_perm_b32 v93, v61, v57, s39
v_perm_b32 v94, v69, v65, s39
v_perm_b32 v95, v77, v73, s39
v_perm_b32 v96, v54, v50, s38
v_perm_b32 v97, v62, v58, s38
v_perm_b32 v98, v70, v66, s38
v_perm_b32 v99, v78, v74, s38
v_perm_b32 v100, v54, v50, s39
v_perm_b32 v101, v62, v58, s39
v_perm_b32 v102, v70, v66, s39
v_perm_b32 v103, v78, v74, s39
v_perm_b32 v104, v55, v51, s38
v_perm_b32 v105, v63, v59, s38
v_perm_b32 v106, v71, v67, s38
v_perm_b32 v107, v79, v75, s38
v_perm_b32 v108, v55, v51, s39
v_perm_b32 v109, v63, v59, s39
v_perm_b32 v110, v71, v67, s39
v_perm_b32 v111, v79, v75, s39
v_mov_b32 v5, 32
ds_read_b32 v125, v5
W_29:
ds_read_b32 v5, v6
s_waitcnt lgkmcnt(0)
v_readfirstlane_b32 s44, v5
s_nop 0
s_cmp_lg_u32 s44, 0
s_cbranch_scc1 WD_30
s_sleep 1
s_sub_u32 s79, s79, 1
s_cbranch_scc0 W_29
s_branch L_DONE
WD_30:
s_setprio 3
ds_read_b128 v[120:123], v10
s_waitcnt lgkmcnt(0)
v_mfma_f32_16x16x32_bf16 v[48:51], v[120:123], v[80:83], 0
v_mfma_f32_16x16x32_bf16 v[52:55], v[120:123], v[84:87], 0
v_mfma_f32_16x16x32_bf16 v[56:59], v[120:123], v[88:91], 0
v_mfma_f32_16x16x32_bf16 v[60:63], v[120:123], v[92:95], 0
v_mfma_f32_16x16x32_bf16 v[64:67], v[120:123], v[96:99], 0
v_mfma_f32_16x16x32_bf16 v[68:71], v[120:123], v[100:103], 0
v_mfma_f32_16x16x32_bf16 v[72:75], v[120:123], v[104:107], 0
v_mfma_f32_16x16x32_bf16 v[76:79], v[120:123], v[108:111], 0
s_nop 0
v_add_f32_dpp v124, v49, v48 row_ror:8 row_mask:0x1 bank_mask:0xf
v_add_f32_dpp v126, v53, v52 row_ror:8 row_mask:0x1 bank_mask:0xf
s_nop 0
v_add_f32_dpp v124, v57, v56 row_ror:8 row_mask:0x2 bank_mask:0xf
v_add_f32_dpp v126, v61, v60 row_ror:8 row_mask:0x2 bank_mask:0xf
s_nop 0
v_add_f32_dpp v124, v65, v64 row_ror:8 row_mask:0x4 bank_mask:0xf
v_add_f32_dpp v126, v69, v68 row_ror:8 row_mask:0x4 bank_mask:0xf
s_nop 0
v_add_f32_dpp v124, v73, v72 row_ror:8 row_mask:0x8 bank_mask:0xf
v_add_f32_dpp v126, v77, v76 row_ror:8 row_mask:0x8 bank_mask:0xf
v_mov_b32 v127, v125
s_mov_b32 s46, 0x00ff00ff
s_mov_b32 s47, 0x00ff00ff
s_mov_b64 exec, s[46:47]
global_store_dwordx4 v9, v[124:127], s[30:31] sc1
s_mov_b64 exec, -1
s_branch L_DONE
L_T2_16:
v_and_b32 v5, 1, v0
v_lshlrev_b32 v5, 5, v5
v_lshl_add_u32 v5, v1, 3, v5
v_lshlrev_b32 v10, 1, v5
v_add_u32 v10, s57, v10
v_lshlrev_b32 v9, 7, v1
v_lshl_add_u32 v9, v4, 4, v9
v_add_u32 v9, s58, v9
v_mov_b32 v6, s56
s_waitcnt vmcnt(0)
v_perm_b32 v80, v20, v16, s38
v_perm_b32 v81, v28, v24, s38
v_perm_b32 v82, v36, v32, s38
v_perm_b32 v83, v44, v40, s38
v_perm_b32 v84, v20, v16, s39
v_perm_b32 v85, v28, v24, s39
v_perm_b32 v86, v36, v32, s39
v_perm_b32 v87, v44, v40, s39
v_perm_b32 v88, v21, v17, s38
v_perm_b32 v89, v29, v25, s38
v_perm_b32 v90, v37, v33, s38
v_perm_b32 v91, v45, v41, s38
v_perm_b32 v92, v21, v17, s39
v_perm_b32 v93, v29, v25, s39
v_perm_b32 v94, v37, v33, s39
v_perm_b32 v95, v45, v41, s39
v_perm_b32 v96, v22, v18, s38
v_perm_b32 v97, v30, v26, s38
v_perm_b32 v98, v38, v34, s38
v_perm_b32 v99, v46, v42, s38
v_perm_b32 v100, v22, v18, s39
v_perm_b32 v101, v30, v26, s39
v_perm_b32 v102, v38, v34, s39
v_perm_b32 v103, v46, v42, s39
v_perm_b32 v104, v23, v19, s38
v_perm_b32 v105, v31, v27, s38
v_perm_b32 v106, v39, v35, s38
v_perm_b32 v107, v47, v43, s38
v_perm_b32 v108, v23, v19, s39
v_perm_b32 v109, v31, v27, s39
v_perm_b32 v110, v39, v35, s39
v_perm_b32 v111, v47, v43, s39
v_mov_b32 v5, 32
ds_read_b32 v125, v5
W_31:
ds_read_b32 v5, v6
s_waitcnt lgkmcnt(0)
v_readfirstlane_b32 s44, v5
s_nop 0
s_cmp_lg_u32 s44, 0
s_cbranch_scc1 WD_32
s_sleep 1
s_sub_u32 s79, s79, 1
s_cbranch_scc0 W_31
s_branch L_DONE
WD_32:
s_setprio 3
ds_read_b128 v[120:123], v10
s_waitcnt lgkmcnt(0)
v_mfma_f32_16x16x32_bf16 v[16:19], v[120:123], v[80:83], 0
v_mfma_f32_16x16x32_bf16 v[20:23], v[120:123], v[84:87], 0
v_mfma_f32_16x16x32_bf16 v[24:27], v[120:123], v[88:91], 0
v_mfma_f32_16x16x32_bf16 v[28:31], v[120:123], v[92:95], 0
v_mfma_f32_16x16x32_bf16 v[32:35], v[120:123], v[96:99], 0
v_mfma_f32_16x16x32_bf16 v[36:39], v[120:123], v[100:103], 0
v_mfma_f32_16x16x32_bf16 v[40:43], v[120:123], v[104:107], 0
v_mfma_f32_16x16x32_bf16 v[44:47], v[120:123], v[108:111], 0
s_nop 0
v_add_f32_dpp v124, v17, v16 row_ror:8 row_mask:0x1 bank_mask:0xf
v_add_f32_dpp v126, v21, v20 row_ror:8 row_mask:0x1 bank_mask:0xf
s_nop 0
v_add_f32_dpp v124, v25, v24 row_ror:8 row_mask:0x2 bank_mask:0xf
v_add_f32_dpp v126, v29, v28 row_ror:8 row_mask:0x2 bank_mask:0xf
s_nop 0
v_add_f32_dpp v124, v33, v32 row_ror:8 row_mask:0x4 bank_mask:0xf
v_add_f32_dpp v126, v37, v36 row_ror:8 row_mask:0x4 bank_mask:0xf
s_nop 0
v_add_f32_dpp v124, v41, v40 row_ror:8 row_mask:0x8 bank_mask:0xf
v_add_f32_dpp v126, v45, v44 row_ror:8 row_mask:0x8 bank_mask:0xf
v_mov_b32 v127, v125
s_mov_b32 s46, 0x00ff00ff
s_mov_b32 s47, 0x00ff00ff
s_mov_b64 exec, s[46:47]
global_store_dwordx4 v9, v[124:127], s[30:31] sc1
s_mov_b64 exec, -1
s_cmp_eq_u32 s55, 2
s_cbranch_scc1 L_FINCHK
s_branch L_DONE
L_ATT:
s_setprio 1
s_sub_u32 s50, s32, 8
s_lshl_b32 s44, s33, 24
s_lshl_b32 s45, s34, 8
s_lshl_b32 s46, s50, 5
s_add_u32 s45, s45, s46
s_add_u32 s45, s45, 61440
s_lshl_b32 s45, s45, 8
s_add_u32 s44, s44, s45
v_lshlrev_b32 v5, 8, v2
v_lshl_add_u32 v5, v1, 4, v5
v_add_u32 v6, 4096, v5
v_lshlrev_b32 v7, 10, v1
v_lshl_add_u32 v7, v2, 4, v7
v_add_u32 v8, 4096, v7
s_waitcnt lgkmcnt(0)
s_add_u32 s56, s10, s44
s_addc_u32 s57, s11, 0
s_add_u32 s58, s12, s44
s_addc_u32 s59, s13, 0
global_load_dwordx4 v[16:19], v5, s[56:57] offset:0 nt
global_load_dwordx4 v[20:23], v5, s[56:57] offset:64 nt
global_load_dwordx4 v[24:27], v5, s[56:57] offset:128 nt
global_load_dwordx4 v[28:31], v5, s[56:57] offset:192 nt
s_barrier
s_waitcnt vmcnt(3)
global_load_dwordx4 v[32:35], v6, s[56:57] offset:0 nt
s_waitcnt vmcnt(3)
global_load_dwordx4 v[36:39], v6, s[56:57] offset:64 nt
s_waitcnt vmcnt(3)
global_load_dwordx4 v[40:43], v6, s[56:57] offset:128 nt
s_waitcnt vmcnt(3)
global_load_dwordx4 v[44:47], v6, s[56:57] offset:192 nt
v_mov_b32 v10, 36
v_mov_b32 v9, 1
s_mov_b64 exec, 1
ds_add_u32 v10, v9
s_mov_b64 exec, -1
v_mov_b32 v10, 36
W_33:
ds_read_b32 v9, v10
s_waitcnt lgkmcnt(0)
v_readfirstlane_b32 s44, v9
s_nop 0
s_cmp_ge_u32 s44, 8
s_cbranch_scc1 WD_34
s_sleep 1
s_sub_u32 s79, s79, 1
s_cbranch_scc0 W_33
s_branch L_DONE
WD_34:
s_waitcnt vmcnt(3)
global_load_dwordx4 v[48:51], v7, s[58:59] offset:0 nt
s_waitcnt vmcnt(3)
global_load_dwordx4 v[52:55], v7, s[58:59] offset:256 nt
s_waitcnt vmcnt(3)
global_load_dwordx4 v[56:59], v7, s[58:59] offset:512 nt
s_waitcnt vmcnt(3)
global_load_dwordx4 v[60:63], v7, s[58:59] offset:768 nt
s_waitcnt vmcnt(3)
global_load_dwordx4 v[64:67], v8, s[58:59] offset:0 nt
s_waitcnt vmcnt(3)
global_load_dwordx4 v[68:71], v8, s[58:59] offset:256 nt
s_waitcnt vmcnt(3)
global_load_dwordx4 v[72:75], v8, s[58:59] offset:512 nt
s_waitcnt vmcnt(3)
global_load_dwordx4 v[76:79], v8, s[58:59] offset:768 nt
v_mov_b32 v10, 16
v_mov_b32 v9, 1
s_mov_b64 exec, 1
ds_add_u32 v10, v9
s_mov_b64 exec, -1
v_mov_b32 v6, 4
W_35:
ds_read_b32 v5, v6
s_waitcnt lgkmcnt(0)
v_readfirstlane_b32 s44, v5
s_nop 0
s_cmp_lg_u32 s44, 0
s_cbranch_scc1 WD_36
s_sleep 1
s_sub_u32 s79, s79, 1
s_cbranch_scc0 W_35
s_branch L_DONE
WD_36:
s_setprio 3
v_and_b32 v5, 1, v0
v_lshlrev_b32 v5, 8, v5
v_lshl_add_u32 v5, v1, 4, v5
ds_read_b128 v[80:83], v5 offset:1536
ds_read_b128 v[84:87], v5 offset:1600
ds_read_b128 v[88:91], v5 offset:1664
ds_read_b128 v[92:95], v5 offset:1728
s_waitcnt vmcnt(8) lgkmcnt(0)
v_mfma_f32_16x16x32_bf16 v[112:115], v[16:19], v[80:83], 0
v_mfma_f32_16x16x32_bf16 v[116:119], v[32:35], v[80:83], 0
v_mfma_f32_16x16x32_bf16 v[112:115], v[20:23], v[84:87], v[112:115]
v_mfma_f32_16x16x32_bf16 v[116:119], v[36:39], v[84:87], v[116:119]
v_mfma_f32_16x16x32_bf16 v[112:115], v[24:27], v[88:91], v[112:115]
v_mfma_f32_16x16x32_bf16 v[116:119], v[40:43], v[88:91], v[116:119]
v_mfma_f32_16x16x32_bf16 v[112:115], v[28:31], v[92:95], v[112:115]
v_mfma_f32_16x16x32_bf16 v[116:119], v[44:47], v[92:95], v[116:119]
s_nop 6
v_max3_f32 v9, v112, v113, v114
v_max3_f32 v9, v9, v115, v116
v_max3_f32 v9, v9, v117, v118
v_max_f32 v9, v9, v119
v_mov_b32 v10, v9
s_nop 1
v_permlane16_swap_b32 v9, v10
v_max_f32 v9, v9, v10
v_mov_b32 v10, v9
s_nop 1
v_permlane32_swap_b32 v9, v10
v_max_f32 v9, v9, v10
s_mov_b32 s44, 0x3e0293ee
v_mul_f32 v9, s44, v9
v_fma_f32 v112, v112, s44, -v9
v_exp_f32 v112, v112
v_fma_f32 v113, v113, s44, -v9
v_exp_f32 v113, v113
v_fma_f32 v114, v114, s44, -v9
v_exp_f32 v114, v114
v_fma_f32 v115, v115, s44, -v9
v_exp_f32 v115, v115
v_fma_f32 v116, v116, s44, -v9
v_exp_f32 v116, v116
v_fma_f32 v117, v117, s44, -v9
v_exp_f32 v117, v117
v_fma_f32 v118, v118, s44, -v9
v_exp_f32 v118, v118
v_fma_f32 v119, v119, s44, -v9
v_exp_f32 v119, v119
v_add_f32 v10, v112, v113
v_add_f32 v10, v10, v114
v_add_f32 v10, v10, v115
v_add_f32 v10, v10, v116
v_add_f32 v10, v10, v117
v_add_f32 v10, v10, v118
v_add_f32 v10, v10, v119
v_cvt_pk_bf16_f32 v120, v112, v113
v_cvt_pk_bf16_f32 v121, v114, v115
v_cvt_pk_bf16_f32 v122, v116, v117
v_cvt_pk_bf16_f32 v123, v118, v119
v_mov_b32 v11, v10
s_nop 1
v_permlane16_swap_b32 v10, v11
v_add_f32 v10, v10, v11
v_mov_b32 v11, v10
s_nop 1
v_permlane32_swap_b32 v10, v11
v_add_f32 v10, v10, v11
v_mov_b32 v12, v9
v_mov_b32 v13, v10
s_waitcnt vmcnt(0)
L_PV:
v_perm_b32 v112, v52, v48, s38
v_perm_b32 v113, v60, v56, s38
v_perm_b32 v114, v68, v64, s38
v_perm_b32 v115, v76, v72, s38
v_perm_b32 v116, v52, v48, s39
v_perm_b32 v117, v60, v56, s39
v_perm_b32 v118, v68, v64, s39
v_perm_b32 v119, v76, v72, s39
v_mfma_f32_16x16x32_bf16 v[80:83], v[120:123], v[112:115], 0
v_perm_b32 v112, v53, v49, s38
v_perm_b32 v113, v61, v57, s38
v_perm_b32 v114, v69, v65, s38
v_perm_b32 v115, v77, v73, s38
v_mfma_f32_16x16x32_bf16 v[84:87], v[120:123], v[116:119], 0
v_perm_b32 v116, v53, v49, s39
v_perm_b32 v117, v61, v57, s39
v_perm_b32 v118, v69, v65, s39
v_perm_b32 v119, v77, v73, s39
v_mfma_f32_16x16x32_bf16 v[88:91], v[120:123], v[112:115], 0
v_perm_b32 v112, v54, v50, s38
v_perm_b32 v113, v62, v58, s38
v_perm_b32 v114, v70, v66, s38
v_perm_b32 v115, v78, v74, s38
v_mfma_f32_16x16x32_bf16 v[92:95], v[120:123], v[116:119], 0
v_perm_b32 v116, v54, v50, s39
v_perm_b32 v117, v62, v58, s39
v_perm_b32 v118, v70, v66, s39
v_perm_b32 v119, v78, v74, s39
v_mfma_f32_16x16x32_bf16 v[96:99], v[120:123], v[112:115], 0
v_perm_b32 v112, v55, v51, s38
v_perm_b32 v113, v63, v59, s38
v_perm_b32 v114, v71, v67, s38
v_perm_b32 v115, v79, v75, s38
v_mfma_f32_16x16x32_bf16 v[100:103], v[120:123], v[116:119], 0
v_perm_b32 v116, v55, v51, s39
v_perm_b32 v117, v63, v59, s39
v_perm_b32 v118, v71, v67, s39
v_perm_b32 v119, v79, v75, s39
v_mfma_f32_16x16x32_bf16 v[104:107], v[120:123], v[112:115], 0
s_nop 0
v_mfma_f32_16x16x32_bf16 v[108:111], v[120:123], v[116:119], 0
s_lshl_b32 s44, s50, 10
s_add_u32 s44, s44, 4096
v_bfe_u32 v5, v0, 1, 2
v_lshlrev_b32 v5, 4, v5
v_lshl_add_u32 v5, v3, 3, v5
v_and_b32 v6, 1, v0
v_lshl_add_u32 v5, v6, 2, v5
v_add_u32 v5, s44, v5
s_lshl_b32 s44, s50, 3
v_lshlrev_b32 v6, 6, v6
v_add_u32 v6, s44, v6
s_mov_b64 exec, 0xffff
ds_write2_b32 v5, v80, v81 offset0:0 offset1:128
ds_write2_b32 v5, v84, v85 offset0:16 offset1:144
ds_write2_b32 v5, v88, v89 offset0:32 offset1:160
ds_write2_b32 v5, v92, v93 offset0:48 offset1:176
ds_write2_b32 v5, v96, v97 offset0:64 offset1:192
ds_write2_b32 v5, v100, v101 offset0:80 offset1:208
ds_write2_b32 v5, v104, v105 offset0:96 offset1:224
ds_write2_b32 v5, v108, v109 offset0:112 offset1:240
s_mov_b64 exec, 3
ds_write_b64 v6, v[12:13] offset:12288
s_mov_b64 exec, -1
s_waitcnt lgkmcnt(0)
v_mov_b32 v6, 8
v_mov_b32 v5, 1
s_mov_b64 exec, 1
ds_add_rtn_u32 v5, v6, v5
s_waitcnt lgkmcnt(0)
v_readfirstlane_b32 s44, v5
s_mov_b64 exec, -1
s_cmp_lg_u32 s44, 7
s_cbranch_scc1 L_ATC
v_lshlrev_b32 v5, 4, v0
v_lshrrev_b32 v6, 5, v0
v_lshlrev_b32 v7, 6, v6
ds_read_b128 v[48:51], v5 offset:4096
ds_read_b128 v[52:55], v5 offset:5120
ds_read_b128 v[56:59], v5 offset:6144
ds_read_b128 v[60:63], v5 offset:7168
ds_read_b128 v[64:67], v5 offset:8192
ds_read_b128 v[68:71], v5 offset:9216
ds_read_b128 v[72:75], v5 offset:10240
ds_read_b128 v[76:79], v5 offset:11264
ds_read_b128 v[80:83], v7 offset:12288
ds_read_b128 v[84:87], v7 offset:12304
ds_read_b128 v[88:91], v7 offset:12320
ds_read_b128 v[92:95], v7 offset:12336
v_mov_b32 v8, 32
ds_read_b32 v101, v8
s_lshl_b32 s44, s33, 2
s_lshl_b32 s44, s44, 13
s_lshl_b32 s45, s34, 9
s_add_u32 s44, s44, s45
s_add_u32 s44, s44, 262144
v_lshlrev_b32 v9, 14, v6
v_and_b32 v10, 31, v0
v_lshl_add_u32 v9, v10, 4, v9
v_add_u32 v9, s44, v9
v_add_u32 v10, 8192, v9
s_mul_i32 s44, s33, 4608
s_lshl_b32 s45, s34, 3
s_add_u32 s44, s44, s45
s_add_u32 s44, s44, 1835008
v_mul_u32_u24 v11, 2304, v6
v_and_b32 v8, 31, v0
v_lshl_add_u32 v11, v8, 7, v11
v_add_u32 v11, s44, v11
s_waitcnt lgkmcnt(0)
v_max3_f32 v96, v80, v82, v84
v_max3_f32 v96, v96, v86, v88
v_max3_f32 v96, v96, v90, v92
v_max_f32 v96, v96, v94
v_sub_f32 v80, v80, v96
v_exp_f32 v80, v80
v_sub_f32 v82, v82, v96
v_exp_f32 v82, v82
v_sub_f32 v84, v84, v96
v_exp_f32 v84, v84
v_sub_f32 v86, v86, v96
v_exp_f32 v86, v86
v_sub_f32 v88, v88, v96
v_exp_f32 v88, v88
v_sub_f32 v90, v90, v96
v_exp_f32 v90, v90
v_sub_f32 v92, v92, v96
v_exp_f32 v92, v92
v_sub_f32 v94, v94, v96
v_exp_f32 v94, v94
v_mul_f32 v98, v80, v81
v_fmac_f32 v98, v82, v83
v_fmac_f32 v98, v84, v85
v_fmac_f32 v98, v86, v87
v_fmac_f32 v98, v88, v89
v_fmac_f32 v98, v90, v91
v_fmac_f32 v98, v92, v93
v_fmac_f32 v98, v94, v95
v_mul_f32 v100, v80, v48
v_mul_f32 v102, v80, v49
v_mul_f32 v104, v80, v50
v_mul_f32 v106, v80, v51
v_fmac_f32 v100, v82, v52
v_fmac_f32 v102, v82, v53
v_fmac_f32 v104, v82, v54
v_fmac_f32 v106, v82, v55
v_fmac_f32 v100, v84, v56
v_fmac_f32 v102, v84, v57
v_fmac_f32 v104, v84, v58
v_fmac_f32 v106, v84, v59
v_fmac_f32 v100, v86, v60
v_fmac_f32 v102, v86, v61
v_fmac_f32 v104, v86, v62
v_fmac_f32 v106, v86, v63
v_fmac_f32 v100, v88, v64
v_fmac_f32 v102, v88, v65
v_fmac_f32 v104, v88, v66
v_fmac_f32 v106, v88, v67
v_fmac_f32 v100, v90, v68
v_fmac_f32 v102, v90, v69
v_fmac_f32 v104, v90, v70
v_fmac_f32 v106, v90, v71
v_fmac_f32 v100, v92, v72
v_fmac_f32 v102, v92, v73
v_fmac_f32 v104, v92, v74
v_fmac_f32 v106, v92, v75
v_fmac_f32 v100, v94, v76
v_fmac_f32 v102, v94, v77
v_fmac_f32 v104, v94, v78
v_fmac_f32 v106, v94, v79
v_rcp_f32 v99, v98
v_log_f32 v98, v98
v_mov_b32 v103, v101
v_mov_b32 v105, v101
v_mov_b32 v107, v101
v_mul_f32 v100, v100, v99
v_mul_f32 v102, v102, v99
v_mul_f32 v104, v104, v99
v_mul_f32 v106, v106, v99
v_add_f32 v96, v96, v98
v_mov_b32 v97, v101
global_store_dwordx4 v9, v[100:103], s[30:31] sc1
global_store_dwordx4 v10, v[104:107], s[30:31] sc1
s_cmp_lt_u32 s33, 8
s_cselect_b32 s46, 0x3, 0x3ffff
s_mov_b32 s47, s46
s_mov_b64 exec, s[46:47]
global_store_dwordx2 v11, v[96:97], s[30:31] sc1
s_mov_b64 exec, -1
s_waitcnt lgkmcnt(0)
v_mov_b32 v6, 40
v_mov_b32 v5, 1
ds_write_b32 v6, v5
L_ATC:
s_setprio 0
s_cmp_lt_u32 s36, 27
s_cbranch_scc1 L_DONE
s_cmp_lt_u32 s50, 6
s_cbranch_scc1 L_FINCHK
s_add_u32 s51, s50, 1
s_mov_b32 s55, 2
v_lshlrev_b32 v5, 5, v3
v_lshl_add_u32 v5, v1, 3, v5
s_lshl_b32 s44, s42, 6
v_add_u32 v6, s44, v5
v_mul_u32_u24 v6, 1152, v6
v_lshl_add_u32 v6, v4, 4, v6
s_lshl_b32 s44, s51, 7
v_add_u32 v6, s44, v6
v_add_u32 v7, 4608, v6
global_load_dwordx4 v[16:19], v6, s[16:17] offset:0 nt
global_load_dwordx4 v[20:23], v6, s[16:17] offset:1152 nt
global_load_dwordx4 v[24:27], v6, s[16:17] offset:2304 nt
global_load_dwordx4 v[28:31], v6, s[16:17] offset:3456 nt
global_load_dwordx4 v[32:35], v7, s[16:17] offset:0 nt
global_load_dwordx4 v[36:39], v7, s[16:17] offset:1152 nt
global_load_dwordx4 v[40:43], v7, s[16:17] offset:2304 nt
global_load_dwordx4 v[44:47], v7, s[16:17] offset:3456 nt
s_mul_i32 s58, s42, 4608
s_lshl_b32 s44, s51, 9
s_add_u32 s58, s58, s44
s_add_u32 s58, s58, 1441792
s_mov_b32 s56, 20
s_mov_b32 s57, 2048
s_branch L_T2_16
L_FINCHK:
s_cmp_lt_u32 s2, 216
s_cbranch_scc1 L_DONE
s_sub_u32 s60, s36, 27
s_lshl_b32 s60, s60, 3
s_add_u32 s60, s60, s35
s_cmp_ge_u32 s60, 36
s_cbranch_scc1 L_DONE
s_lshl_b32 s61, s60, 7
v_lshrrev_b32 v5, 3, v0
s_lshl_b32 s44, s50, 3
v_add_u32 v6, s44, v5
v_mul_u32_u24 v6, 4608, v6
v_lshl_add_u32 v6, v4, 4, v6
v_add_u32 v6, s61, v6
v_add_u32 v6, 1441792, v6
s_mul_i32 s44, s50, 9
v_add_u32 v7, s44, v5
v_mul_u32_u24 v7, 4608, v7
v_lshl_add_u32 v7, v4, 4, v7
v_add_u32 v7, s61, v7
v_add_u32 v7, 1048576, v7
s_add_u32 s44, s44, 8
s_mul_i32 s44, s44, 4608
s_add_u32 s44, s44, s61
s_add_u32 s44, s44, 1048576
v_lshlrev_b32 v8, 4, v4
v_add_u32 v8, s44, v8
v_mov_b32 v9, 32
ds_read_b32 v14, v9
s_lshr_b32 s62, s60, 2
s_lshl_b32 s62, s62, 7
s_and_b32 s44, s60, 3
s_lshl_b32 s44, s44, 2
s_add_u32 s62, s62, s44
v_lshlrev_b32 v10, 4, v4
v_add_u32 v10, s62, v10
global_load_dword v15, v10, s[8:9]
s_waitcnt lgkmcnt(0)
v_mov_b32 v24, 0
v_mov_b32 v25, v14
v_mov_b32 v26, 0
v_mov_b32 v27, v14
v_mov_b32 v29, 20
W_37:
ds_read_b32 v28, v29
s_waitcnt lgkmcnt(0)
v_readfirstlane_b32 s44, v28
s_nop 0
s_cmp_lg_u32 s44, 0
s_cbranch_scc1 WD_38
s_sleep 1
s_sub_u32 s79, s79, 1
s_cbranch_scc0 W_37
s_branch L_DONE
WD_38:
v_mov_b32 v40, 0
v_mov_b32 v41, v14
v_mov_b32 v42, 0
v_mov_b32 v43, v14
global_load_dwordx4 v[16:19], v6, s[30:31] sc1
global_load_dwordx4 v[20:23], v7, s[30:31] sc1
s_mov_b64 exec, 0xff
global_load_dwordx4 v[24:27], v8, s[30:31] sc1
s_mov_b64 exec, -1
L_FSW:
s_sleep 2
global_load_dwordx4 v[32:35], v6, s[30:31] sc1
global_load_dwordx4 v[36:39], v7, s[30:31] sc1
s_mov_b64 exec, 0xff
global_load_dwordx4 v[40:43], v8, s[30:31] sc1
s_mov_b64 exec, -1
s_waitcnt vmcnt(3)
v_xor_b32 v29, v14, v17
v_xor_b32 v30, v14, v19
v_or_b32 v29, v29, v30
v_xor_b32 v30, v14, v21
v_or_b32 v29, v29, v30
v_xor_b32 v30, v14, v23
v_or_b32 v29, v29, v30
v_xor_b32 v30, v14, v25
v_or_b32 v29, v29, v30
v_xor_b32 v30, v14, v27
v_or_b32 v29, v29, v30
v_cmp_ne_u32 vcc, 0, v29
s_cbranch_vccz L_FOKA
s_sleep 2
global_load_dwordx4 v[16:19], v6, s[30:31] sc1
global_load_dwordx4 v[20:23], v7, s[30:31] sc1
s_mov_b64 exec, 0xff
global_load_dwordx4 v[24:27], v8, s[30:31] sc1
s_mov_b64 exec, -1
s_waitcnt vmcnt(3)
v_xor_b32 v29, v14, v33
v_xor_b32 v30, v14, v35
v_or_b32 v29, v29, v30
v_xor_b32 v30, v14, v37
v_or_b32 v29, v29, v30
v_xor_b32 v30, v14, v39
v_or_b32 v29, v29, v30
v_xor_b32 v30, v14, v41
v_or_b32 v29, v29, v30
v_xor_b32 v30, v14, v43
v_or_b32 v29, v29, v30
v_cmp_ne_u32 vcc, 0, v29
s_cbranch_vccz L_FOKB
s_sub_u32 s79, s79, 1
s_cbranch_scc0 L_FSW
s_branch L_DONE
L_FOKB:
v_mov_b32 v44, v32
v_mov_b32 v46, v34
v_add_f32 v48, v36, v40
v_add_f32 v50, v38, v42
s_branch L_FRED
L_FOKA:
v_mov_b32 v44, v16
v_mov_b32 v46, v18
v_add_f32 v48, v20, v24
v_add_f32 v50, v22, v26
L_FRED:
v_lshlrev_b32 v9, 4, v4
v_add_f32_dpp v44, v44, v44 row_ror:8 row_mask:0xf bank_mask:0xf
v_add_f32_dpp v46, v46, v46 row_ror:8 row_mask:0xf bank_mask:0xf
v_add_f32_dpp v48, v48, v48 row_ror:8 row_mask:0xf bank_mask:0xf
v_add_f32_dpp v50, v50, v50 row_ror:8 row_mask:0xf bank_mask:0xf
v_mov_b32 v45, v44
v_mov_b32 v47, v46
v_mov_b32 v49, v48
v_mov_b32 v51, v50
v_permlane16_swap_b32 v44, v45
v_permlane16_swap_b32 v46, v47
v_permlane16_swap_b32 v48, v49
v_permlane16_swap_b32 v50, v51
v_add_f32 v44, v44, v45
v_add_f32 v46, v46, v47
v_add_f32 v48, v48, v49
v_add_f32 v50, v50, v51
v_mov_b32 v45, v44
v_mov_b32 v47, v46
v_mov_b32 v49, v48
v_mov_b32 v51, v50
v_permlane32_swap_b32 v44, v45
v_permlane32_swap_b32 v46, v47
v_permlane32_swap_b32 v48, v49
v_permlane32_swap_b32 v50, v51
v_add_f32 v44, v44, v45
v_add_f32 v46, v46, v47
v_add_f32 v48, v48, v49
v_add_f32 v50, v50, v51
s_mov_b64 exec, 0xff
ds_add_f32 v9, v44 offset:64
ds_add_f32 v9, v46 offset:68
ds_add_f32 v9, v48 offset:72
ds_add_f32 v9, v50 offset:76
s_mov_b64 exec, -1
s_waitcnt lgkmcnt(0)
v_mov_b32 v6, 28
v_mov_b32 v5, 1
s_mov_b64 exec, 1
ds_add_rtn_u32 v5, v6, v5
s_waitcnt lgkmcnt(0)
v_readfirstlane_b32 s44, v5
s_mov_b64 exec, -1
s_cmp_lg_u32 s44, 7
s_cbranch_scc1 L_DONE
ds_read_b128 v[52:55], v9 offset:64
s_waitcnt lgkmcnt(0)
v_cvt_pk_bf16_f32 v52, v52, v52
v_lshlrev_b32 v52, 16, v52
v_cvt_pk_bf16_f32 v54, v54, v54
v_lshlrev_b32 v54, 16, v54
v_cvt_pk_bf16_f32 v53, v53, v53
v_lshlrev_b32 v53, 16, v53
v_cvt_pk_bf16_f32 v55, v55, v55
v_lshlrev_b32 v55, 16, v55
v_mul_f32 v56, 0xbfb8aa3b, v54
v_mul_f32 v57, 0xbfb8aa3b, v55
v_exp_f32 v56, v56
v_exp_f32 v57, v57
v_add_f32 v56, 1.0, v56
v_add_f32 v57, 1.0, v57
v_rcp_f32 v56, v56
v_rcp_f32 v57, v57
v_mul_f32 v54, v54, v56
v_mul_f32 v55, v55, v57
v_cvt_pk_bf16_f32 v54, v54, v54
v_lshlrev_b32 v54, 16, v54
v_cvt_pk_bf16_f32 v55, v55, v55
v_lshlrev_b32 v55, 16, v55
v_mul_f32 v52, v52, v54
v_mul_f32 v53, v53, v55
v_cvt_pk_bf16_f32 v52, v52, v52
v_lshlrev_b32 v52, 16, v52
v_cvt_pk_bf16_f32 v53, v53, v53
v_lshlrev_b32 v53, 16, v53
v_lshlrev_b32 v56, 16, v15
v_and_b32 v57, 0xffff0000, v15
v_add_f32 v52, v52, v56
v_add_f32 v53, v53, v57
v_cvt_pk_bf16_f32 v52, v52, v53
s_mov_b64 exec, 0xff
global_store_dword v10, v52, s[26:27]
s_mov_b64 exec, -1
s_cmp_lg_u32 s60, 0
s_cbranch_scc1 L_DONE
v_mov_b32 v5, 0
s_mov_b64 exec, 1
global_store_dword v5, v14, s[30:31]
s_mov_b64 exec, -1
L_DONE:
L_END:
s_endpgm
.section .rodata,"a"
.p2align 6
.amdhsa_kernel recurrent_scan__sliding_block_cached__swiglu_ffn__decode_kernel
  .amdhsa_next_free_vgpr 128
  .amdhsa_next_free_sgpr 102
  .amdhsa_accum_offset 128
  .amdhsa_group_segment_fixed_size 0
  .amdhsa_kernarg_size 96
  .amdhsa_user_sgpr_count 2
  .amdhsa_user_sgpr_kernarg_segment_ptr 1
  .amdhsa_system_sgpr_workgroup_id_x 1
.end_amdhsa_kernel
```
